```python
import torch

def _softmax(x, axis=-1):
    return torch.softmax(x, dim=axis)
def _gelu(x):
    return torch.nn.functional.gelu(x, approximate="tanh")
def _silu(x):
    return torch.nn.functional.silu(x)
def _sigmoid(x):
    return torch.sigmoid(x)
def _layernorm(x, axis=-1, eps=1e-5):
    m = x.mean(dim=axis, keepdim=True)
    v = x.var(dim=axis, keepdim=True, unbiased=False)
    return (x - m) / torch.sqrt(v + eps)
def _scatter_add(tgt, idx, src, axis=0):
    return tgt.clone().index_add_(axis, idx, src)
def _segment_sum(src, seg, n):
    out = torch.zeros((n,) + src.shape[1:], dtype=src.dtype)
    return out.index_add_(0, seg, src)
def _pad(x, pw):
    flat = tuple(v for pair in reversed(pw) for v in pair)
    return torch.nn.functional.pad(x, flat)

kernel_name = 'parallel_sum__gqa_block_cached__swiglu_ffn__decode'

def setup_inputs():

    _w = (lambda a: (lambda t: t.to(torch.bfloat16) if t.is_floating_point() else t)(torch.as_tensor(a)))
    def _A_setup():
        B, Sq, D = 8, 1, 576
        Hq, Hkv, Sk, Dh = 32, 16, 8192, 128
        assert Hq % Hkv == 0, (Hq, Hkv)
        return {
            "x": _w((lambda *s: torch.randn(*s, dtype=torch.bfloat16) * 0.05)(B, Sq, D)),
            "k_cache": _w((lambda *s: torch.randn(*s, dtype=torch.bfloat16) * 3.2)(B, Hkv, Sk, Dh)),
            "v_cache": _w((lambda *s: torch.randn(*s, dtype=torch.bfloat16) * 1.6)(B, Hkv, Sk, Dh)),
            "wq": _w((lambda *s: torch.randn(*s, dtype=torch.bfloat16) * 3.2)(D, Hq * Dh) * (D ** -0.5)),
            "wo": _w((lambda *s: torch.randn(*s, dtype=torch.bfloat16) * 1.6)(Hq * Dh, D) * ((Hq * Dh) ** -0.5)),
        }
    _A_in = _A_setup()

    def _B_setup():
        B, S, D, F = 8, 1, 576, 4608
        return {
            "x": _w((lambda *s: torch.randn(*s, dtype=torch.bfloat16) * 0.05)(B, S, D)),
            "w_gate": _w((lambda *s: torch.randn(*s, dtype=torch.bfloat16) * 0.05)(D, F)),
            "w_up": _w((lambda *s: torch.randn(*s, dtype=torch.bfloat16) * 0.05)(D, F)),
            "w_down": _w((lambda *s: torch.randn(*s, dtype=torch.bfloat16) * 0.05)(F, D)),
        }
    _B_in = _B_setup()

    return {
        "A_x": _A_in["x"],
        "A_k_cache": _A_in["k_cache"],
        "A_v_cache": _A_in["v_cache"],
        "A_wq": _A_in["wq"],
        "A_wo": _A_in["wo"],
        "B_x": _B_in["x"],
        "B_w_gate": _B_in["w_gate"],
        "B_w_up": _B_in["w_up"],
        "B_w_down": _B_in["w_down"],
    }

def reference(A_x, A_k_cache, A_v_cache, A_wq, A_wo, B_x, B_w_gate, B_w_up, B_w_down):
    def _A_ref(x, k_cache, v_cache, wq, wo):
        B, Sq, D = x.shape
        Hq, Dh = 32, 128
        Hkv = k_cache.shape[1]
        rep = Hq // Hkv
        q = (lambda x, *d: x.permute(*d))((x @ wq).reshape(B, Sq, Hq, Dh), 0, 2, 1, 3)
        k = (lambda x, n, axis: torch.repeat_interleave(x, n, dim=axis))(k_cache, rep, axis=1)
        v = (lambda x, n, axis: torch.repeat_interleave(x, n, dim=axis))(v_cache, rep, axis=1)
        scores = torch.einsum("bhqd,bhkd->bhqk", q, k) * (Dh ** -0.5)
        p = _softmax(scores, axis=-1)
        o = torch.einsum("bhqk,bhkd->bhqd", p, v)
        return (lambda x, *d: x.permute(*d))(o, 0, 2, 1, 3).reshape(B, Sq, Hq * Dh) @ wo

    def _B_ref(x, w_gate, w_up, w_down):
        g = _silu(x @ w_gate)
        u = x @ w_up
        return (g * u) @ w_down

    x = A_x
    xn = _layernorm(x, axis=-1)
    return x + _A_ref(xn, A_k_cache, A_v_cache, A_wq, A_wo) + _B_ref(xn, B_w_gate, B_w_up, B_w_down)
```

```asm
; @launch grid=(256,1,1) block=(512,1,1) lds=128000
.amdgcn_target "amdgcn-amd-amdhsa--gfx950"
.text
.globl parallel_sum__gqa_block_cached__swiglu_ffn__decode_kernel
.p2align 8
.type parallel_sum__gqa_block_cached__swiglu_ffn__decode_kernel,@function
parallel_sum__gqa_block_cached__swiglu_ffn__decode_kernel:

    s_cmp_ge_u32 s2, 256
    s_cbranch_scc1 F_end2
    s_load_dwordx16 s[4:19], s[0:1], 0
    s_load_dwordx8 s[20:27], s[0:1], 64
    s_getpc_b64 s[40:41]
F_pc:
    s_sub_u32 s40, s40, F_pc-parallel_sum__gqa_block_cached__swiglu_ffn__decode_kernel
    s_subb_u32 s41, s41, 0
    v_lshlrev_b32 v1, 7, v0
    v_cmp_gt_u32 vcc, 10496, v1
    s_and_saveexec_b64 s[42:43], vcc
    s_cbranch_execz F_pc_done
    global_load_dword v255, v1, s[40:41]
F_pc_done:
    s_mov_b64 exec, s[42:43]
    v_and_b32 v1, 63, v0
    v_lshrrev_b32 v10, 6, v0
    v_lshrrev_b32 v2, 4, v1
    v_readfirstlane_b32 s3, v10
    v_and_b32 v3, 15, v0
    v_mov_b32 v58, 0
    v_mov_b32 v59, 0
    s_and_b32 s31, s2, 1
    s_bfe_u32 s29, s2, 0x20001
    s_lshr_b32 s30, s2, 3
    s_lshl_b32 s30, s30, 2
    s_add_u32 s94, s30, s29
    s_lshr_b32 s30, s94, 4
    s_and_b32 s29, s94, 15
    s_lshl_b32 s32, s30, 5
    s_lshl_b32 s33, s29, 1
    s_add_u32 s32, s32, s33
    s_add_u32 s32, s32, s31
    s_sub_u32 s34, s3, 4
    s_lshl_b32 s94, s30, 4
    s_add_u32 s94, s94, s29
    s_mov_b32 s33, 1
    s_mov_b32 s95, s94
    s_cmp_eq_u32 s31, 1
    s_cbranch_scc1 F_cls_done
    s_mov_b32 s33, 0
    s_cmp_lt_u32 s30, 4
    s_cbranch_scc1 F_cls_done
    s_mov_b32 s33, 1
    s_add_u32 s95, s94, 64
    s_cmp_eq_u32 s30, 4
    s_cbranch_scc1 F_cls_done
    s_mov_b32 s33, 2
    s_sub_u32 s95, s94, 80
F_cls_done:
    v_mov_b32 v10, 0
    v_lshlrev_b32 v11, 2, v1
    s_mov_b64 exec, 0xffff
    ds_write_b32 v11, v10 offset:10496
    s_mov_b64 exec, -1
    s_mul_i32 s77, s95, 57
    s_lshr_b32 s77, s77, 9
    s_lshl_b32 s83, s3, 5
    s_lshl_b32 s61, s77, 1
    s_add_u32 s83, s83, s61
    s_mul_i32 s83, s83, 2304
    s_add_u32 s83, s83, 524288
    s_add_u32 s84, s83, 2304
    s_cmp_ge_u32 s3, 4
    s_cbranch_scc1 F_helper
    v_and_b32 v10, 1, v3
    v_mov_b32 v11, 0xffff
    v_mov_b32 v12, 0xffff0000
    v_cmp_eq_u32 vcc, 1, v10
    v_bfe_u32 v10, v3, 1, 2
    s_nop 0
    v_cndmask_b32 v11, v11, v12, vcc
    v_cmp_eq_u32 vcc, 0, v10
    s_nop 1
    v_cndmask_b32 v6, 0, v11, vcc
    v_cmp_eq_u32 vcc, 1, v10
    s_nop 1
    v_cndmask_b32 v7, 0, v11, vcc
    v_cmp_eq_u32 vcc, 2, v10
    s_nop 1
    v_cndmask_b32 v8, 0, v11, vcc
    v_cmp_eq_u32 vcc, 3, v10
    s_nop 1
    v_cndmask_b32 v9, 0, v11, vcc
    v_lshlrev_b32 v10, 8, v3
    v_lshl_add_u32 v10, v2, 4, v10
    v_lshlrev_b32 v11, 10, v2
    v_lshl_add_u32 v11, v3, 4, v11
    v_lshrrev_b32 v14, 3, v3
    v_lshlrev_b32 v14, 9, v14
    v_lshl_add_u32 v14, v2, 5, v14
    s_mov_b32 s59, 253
    s_cmp_lt_u32 s30, 4
    s_cselect_b32 s59, s59, 253
    s_cmp_eq_u32 s30, 4
    s_cselect_b32 s59, 256, s59
    s_sub_u32 s58, 512, s59
    s_lshl_b32 s61, s59, 12
    s_cmp_eq_u32 s31, 0
    s_cselect_b32 s58, s59, s58
    s_cselect_b32 s61, 0, s61
    s_lshl_b32 s60, s94, 21
    s_add_u32 s60, s60, s61
    s_lshl_b32 s57, s58, 12
    s_sub_u32 s58, s58, s3
    s_add_u32 s58, s58, 3
    s_lshr_b32 s58, s58, 2
    s_mul_i32 s66, s30, 53248
    s_lshl_b32 s61, s29, 10
    s_add_u32 s66, s66, s61
    s_add_u32 s66, s66, 4096
    s_lshl_b32 s64, s3, 12
    s_lshl_b32 s65, s3, 12
    s_waitcnt lgkmcnt(0)
    s_load_dword s28, s[26:27], 0
    s_barrier
    s_mov_b32 s36, s26
    s_mov_b32 s37, s27
    s_mov_b32 s38, 3145728
    s_mov_b32 s39, 0x00020000
    s_add_u32 s40, s6, s60
    s_addc_u32 s41, s7, 0
    s_mov_b32 s42, s57
    s_mov_b32 s43, 0x00020000
    s_add_u32 s44, s8, s60
    s_addc_u32 s45, s9, 0
    s_mov_b32 s46, s57
    s_mov_b32 s47, 0x00020000
    v_lshlrev_b32 v14, 4, v1
    s_barrier
    buffer_load_dwordx4 v[64:67], v10, s[40:43], s64 offen offset:0 nt
    buffer_load_dwordx4 v[68:71], v10, s[40:43], s64 offen offset:64 nt
    buffer_load_dwordx4 v[72:75], v10, s[40:43], s64 offen offset:128 nt
    buffer_load_dwordx4 v[76:79], v10, s[40:43], s64 offen offset:192 nt
    s_add_u32 s64, s64, 16384
    buffer_load_dwordx4 v[80:83], v11, s[44:47], s65 offen offset:0 nt
    buffer_load_dwordx4 v[84:87], v11, s[44:47], s65 offen offset:256 nt
    buffer_load_dwordx4 v[88:91], v11, s[44:47], s65 offen offset:512 nt
    buffer_load_dwordx4 v[92:95], v11, s[44:47], s65 offen offset:768 nt
    s_add_u32 s65, s65, 16384
    buffer_load_dwordx4 v[96:99], v10, s[40:43], s64 offen offset:0 nt
    buffer_load_dwordx4 v[100:103], v10, s[40:43], s64 offen offset:64 nt
    buffer_load_dwordx4 v[104:107], v10, s[40:43], s64 offen offset:128 nt
    buffer_load_dwordx4 v[108:111], v10, s[40:43], s64 offen offset:192 nt
    s_add_u32 s64, s64, 16384
    buffer_load_dwordx4 v[112:115], v11, s[44:47], s65 offen offset:0 nt
    buffer_load_dwordx4 v[116:119], v11, s[44:47], s65 offen offset:256 nt
    buffer_load_dwordx4 v[120:123], v11, s[44:47], s65 offen offset:512 nt
    buffer_load_dwordx4 v[124:127], v11, s[44:47], s65 offen offset:768 nt
    s_add_u32 s65, s65, 16384
    buffer_load_dwordx4 v[128:131], v10, s[40:43], s64 offen offset:0 nt
    buffer_load_dwordx4 v[132:135], v10, s[40:43], s64 offen offset:64 nt
    buffer_load_dwordx4 v[136:139], v10, s[40:43], s64 offen offset:128 nt
    buffer_load_dwordx4 v[140:143], v10, s[40:43], s64 offen offset:192 nt
    s_add_u32 s64, s64, 16384
    buffer_load_dwordx4 v[144:147], v11, s[44:47], s65 offen offset:0 nt
    buffer_load_dwordx4 v[148:151], v11, s[44:47], s65 offen offset:256 nt
    buffer_load_dwordx4 v[152:155], v11, s[44:47], s65 offen offset:512 nt
    buffer_load_dwordx4 v[156:159], v11, s[44:47], s65 offen offset:768 nt
    s_add_u32 s65, s65, 16384
    buffer_load_dwordx4 v[192:195], v14, s[36:39], s66 offen sc1
    buffer_load_dwordx4 v[160:163], v10, s[40:43], s64 offen offset:0 nt
    buffer_load_dwordx4 v[164:167], v10, s[40:43], s64 offen offset:64 nt
    buffer_load_dwordx4 v[168:171], v10, s[40:43], s64 offen offset:128 nt
    buffer_load_dwordx4 v[172:175], v10, s[40:43], s64 offen offset:192 nt
    s_add_u32 s64, s64, 16384
    buffer_load_dwordx4 v[176:179], v11, s[44:47], s65 offen offset:0 nt
    buffer_load_dwordx4 v[180:183], v11, s[44:47], s65 offen offset:256 nt
    buffer_load_dwordx4 v[184:187], v11, s[44:47], s65 offen offset:512 nt
    buffer_load_dwordx4 v[188:191], v11, s[44:47], s65 offen offset:768 nt
    s_add_u32 s65, s65, 16384
    s_waitcnt lgkmcnt(0)
    s_add_u32 s28, s28, 1
    s_mov_b32 s67, 200000
    s_waitcnt vmcnt(8)
    s_branch L_q_chk_3
L_q_poll_1:
    buffer_load_dwordx4 v[192:195], v14, s[36:39], s66 offen sc1
    s_waitcnt vmcnt(0)
L_q_chk_3:
    v_xor_b32 v193, s28, v193
    v_xor_b32 v195, s28, v195
    v_or_b32 v56, v193, v195
    v_cmp_ne_u32 vcc, 0, v56
    s_nop 4
    s_cbranch_vccz L_q_ok_2
    s_sleep 1
    s_sub_u32 s67, s67, 1
    s_cmp_lg_u32 s67, 0
    s_cbranch_scc1 L_q_poll_1
L_q_ok_2:
    v_mov_b32 v193, v194
    s_lshl_b32 s60, s3, 9
    s_add_u32 s60, s60, 14848
    v_lshlrev_b32 v56, 3, v1
    v_add_u32 v56, s60, v56
    ds_write_b64 v56, v[192:193]
    v_lshrrev_b32 v57, 3, v3
    v_lshlrev_b32 v57, 8, v57
    v_lshl_add_u32 v57, v2, 4, v57
    v_add_u32 v57, s60, v57
    s_waitcnt lgkmcnt(0)
    ds_read_b128 v[40:43], v57 offset:0
    ds_read_b128 v[44:47], v57 offset:64
    ds_read_b128 v[48:51], v57 offset:128
    ds_read_b128 v[52:55], v57 offset:192
    s_waitcnt lgkmcnt(0)
    s_mul_i32 s60, s3, 544
    v_lshlrev_b32 v15, 3, v1
    v_add_u32 v15, s60, v15
    v_mov_b32 v12, 0xff7fffff
    v_mov_b32 v13, 0
    v_mov_b32 v16, 0
    v_mov_b32 v17, 0
    v_mov_b32 v18, 0
    v_mov_b32 v19, 0
    s_mov_b32 s60, 0x3db504f3
    s_mov_b32 s61, 0x3fb8aa3b
    s_mov_b32 s62, s58
F_loop:
    s_waitcnt vmcnt(28)
    v_mfma_f32_16x16x32_bf16 v[20:23], v[64:67], v[40:43], 0
    v_mfma_f32_16x16x32_bf16 v[20:23], v[68:71], v[44:47], v[20:23]
    v_mfma_f32_16x16x32_bf16 v[20:23], v[72:75], v[48:51], v[20:23]
    v_mfma_f32_16x16x32_bf16 v[20:23], v[76:79], v[52:55], v[20:23]
    buffer_load_dwordx4 v[64:67], v10, s[40:43], s64 offen offset:0 nt
    buffer_load_dwordx4 v[68:71], v10, s[40:43], s64 offen offset:64 nt
    buffer_load_dwordx4 v[72:75], v10, s[40:43], s64 offen offset:128 nt
    buffer_load_dwordx4 v[76:79], v10, s[40:43], s64 offen offset:192 nt
    s_add_u32 s64, s64, 16384
    s_nop 2
    v_cvt_pk_bf16_f32 v56, v20, v21
    v_cvt_pk_bf16_f32 v57, v22, v23
    v_lshlrev_b32 v24, 16, v56
    v_and_b32 v25, 0xffff0000, v56
    v_lshlrev_b32 v26, 16, v57
    v_and_b32 v27, 0xffff0000, v57
    v_mul_f32 v24, s60, v24
    v_mul_f32 v25, s60, v25
    v_mul_f32 v26, s60, v26
    v_mul_f32 v27, s60, v27
    v_cvt_pk_bf16_f32 v56, v24, v25
    v_cvt_pk_bf16_f32 v57, v26, v27
    v_lshlrev_b32 v24, 16, v56
    v_and_b32 v25, 0xffff0000, v56
    v_lshlrev_b32 v26, 16, v57
    v_and_b32 v27, 0xffff0000, v57
    v_max3_f32 v56, v24, v25, v26
    v_max3_f32 v56, v56, v27, v12
    v_mov_b32 v57, v56
    s_nop 1
    v_permlane16_swap_b32 v56, v57
    s_nop 1
    v_max_f32 v56, v56, v57
    v_mov_b32 v57, v56
    s_nop 1
    v_permlane32_swap_b32 v56, v57
    s_nop 1
    v_max_f32 v56, v56, v57
    v_sub_f32 v57, v12, v56
    v_mul_f32 v57, s61, v57
    v_exp_f32 v57, v57
    v_mov_b32 v12, v56
    v_mul_f32 v58, s61, v56
    v_fma_f32 v28, v24, s61, -v58
    v_fma_f32 v29, v25, s61, -v58
    v_fma_f32 v30, v26, s61, -v58
    v_fma_f32 v31, v27, s61, -v58
    v_exp_f32 v28, v28
    v_exp_f32 v29, v29
    v_exp_f32 v30, v30
    v_exp_f32 v31, v31
    v_mul_f32 v16, v16, v57
    v_mul_f32 v17, v17, v57
    v_mul_f32 v18, v18, v57
    v_mul_f32 v19, v19, v57
    v_fma_f32 v13, v13, v57, v28
    v_add_f32 v13, v13, v29
    v_add_f32 v13, v13, v30
    v_add_f32 v13, v13, v31
    v_cvt_pk_bf16_f32 v28, v28, v28
    v_cvt_pk_bf16_f32 v29, v29, v29
    v_cvt_pk_bf16_f32 v30, v30, v30
    v_cvt_pk_bf16_f32 v31, v31, v31
    s_waitcnt vmcnt(28)
    v_and_b32 v32, v28, v6
    v_and_b32 v33, v28, v7
    v_and_b32 v34, v28, v8
    v_and_b32 v35, v28, v9
    v_and_b32 v36, v29, v6
    v_and_b32 v37, v29, v7
    v_and_b32 v38, v29, v8
    v_and_b32 v39, v29, v9
    v_mfma_f32_16x16x32_bf16 v[16:19], v[80:83], v[32:35], v[16:19]
    v_and_b32 v32, v30, v6
    v_and_b32 v33, v30, v7
    v_and_b32 v34, v30, v8
    v_and_b32 v35, v30, v9
    v_mfma_f32_16x16x32_bf16 v[16:19], v[84:87], v[36:39], v[16:19]
    v_and_b32 v36, v31, v6
    v_and_b32 v37, v31, v7
    v_and_b32 v38, v31, v8
    v_and_b32 v39, v31, v9
    v_mfma_f32_16x16x32_bf16 v[16:19], v[88:91], v[32:35], v[16:19]
    s_nop 0
    v_mfma_f32_16x16x32_bf16 v[16:19], v[92:95], v[36:39], v[16:19]
    buffer_load_dwordx4 v[80:83], v11, s[44:47], s65 offen offset:0 nt
    buffer_load_dwordx4 v[84:87], v11, s[44:47], s65 offen offset:256 nt
    buffer_load_dwordx4 v[88:91], v11, s[44:47], s65 offen offset:512 nt
    buffer_load_dwordx4 v[92:95], v11, s[44:47], s65 offen offset:768 nt
    s_add_u32 s65, s65, 16384
    s_sub_u32 s62, s62, 1
    s_cmp_lg_u32 s62, 6
    s_cbranch_scc1 L_trig_4
    v_mov_b32 v58, 10500
    v_mov_b32 v59, 1
    ds_write_b32 v58, v59
L_trig_4:
    s_cmp_eq_u32 s62, 0
    s_cbranch_scc1 F_loop_exit
    s_waitcnt vmcnt(28)
    v_mfma_f32_16x16x32_bf16 v[20:23], v[96:99], v[40:43], 0
    v_mfma_f32_16x16x32_bf16 v[20:23], v[100:103], v[44:47], v[20:23]
    v_mfma_f32_16x16x32_bf16 v[20:23], v[104:107], v[48:51], v[20:23]
    v_mfma_f32_16x16x32_bf16 v[20:23], v[108:111], v[52:55], v[20:23]
    buffer_load_dwordx4 v[96:99], v10, s[40:43], s64 offen offset:0 nt
    buffer_load_dwordx4 v[100:103], v10, s[40:43], s64 offen offset:64 nt
    buffer_load_dwordx4 v[104:107], v10, s[40:43], s64 offen offset:128 nt
    buffer_load_dwordx4 v[108:111], v10, s[40:43], s64 offen offset:192 nt
    s_add_u32 s64, s64, 16384
    s_nop 2
    v_cvt_pk_bf16_f32 v56, v20, v21
    v_cvt_pk_bf16_f32 v57, v22, v23
    v_lshlrev_b32 v24, 16, v56
    v_and_b32 v25, 0xffff0000, v56
    v_lshlrev_b32 v26, 16, v57
    v_and_b32 v27, 0xffff0000, v57
    v_mul_f32 v24, s60, v24
    v_mul_f32 v25, s60, v25
    v_mul_f32 v26, s60, v26
    v_mul_f32 v27, s60, v27
    v_cvt_pk_bf16_f32 v56, v24, v25
    v_cvt_pk_bf16_f32 v57, v26, v27
    v_lshlrev_b32 v24, 16, v56
    v_and_b32 v25, 0xffff0000, v56
    v_lshlrev_b32 v26, 16, v57
    v_and_b32 v27, 0xffff0000, v57
    v_max3_f32 v56, v24, v25, v26
    v_max3_f32 v56, v56, v27, v12
    v_mov_b32 v57, v56
    s_nop 1
    v_permlane16_swap_b32 v56, v57
    s_nop 1
    v_max_f32 v56, v56, v57
    v_mov_b32 v57, v56
    s_nop 1
    v_permlane32_swap_b32 v56, v57
    s_nop 1
    v_max_f32 v56, v56, v57
    v_sub_f32 v57, v12, v56
    v_mul_f32 v57, s61, v57
    v_exp_f32 v57, v57
    v_mov_b32 v12, v56
    v_mul_f32 v58, s61, v56
    v_fma_f32 v28, v24, s61, -v58
    v_fma_f32 v29, v25, s61, -v58
    v_fma_f32 v30, v26, s61, -v58
    v_fma_f32 v31, v27, s61, -v58
    v_exp_f32 v28, v28
    v_exp_f32 v29, v29
    v_exp_f32 v30, v30
    v_exp_f32 v31, v31
    v_mul_f32 v16, v16, v57
    v_mul_f32 v17, v17, v57
    v_mul_f32 v18, v18, v57
    v_mul_f32 v19, v19, v57
    v_fma_f32 v13, v13, v57, v28
    v_add_f32 v13, v13, v29
    v_add_f32 v13, v13, v30
    v_add_f32 v13, v13, v31
    v_cvt_pk_bf16_f32 v28, v28, v28
    v_cvt_pk_bf16_f32 v29, v29, v29
    v_cvt_pk_bf16_f32 v30, v30, v30
    v_cvt_pk_bf16_f32 v31, v31, v31
    s_waitcnt vmcnt(28)
    v_and_b32 v32, v28, v6
    v_and_b32 v33, v28, v7
    v_and_b32 v34, v28, v8
    v_and_b32 v35, v28, v9
    v_and_b32 v36, v29, v6
    v_and_b32 v37, v29, v7
    v_and_b32 v38, v29, v8
    v_and_b32 v39, v29, v9
    v_mfma_f32_16x16x32_bf16 v[16:19], v[112:115], v[32:35], v[16:19]
    v_and_b32 v32, v30, v6
    v_and_b32 v33, v30, v7
    v_and_b32 v34, v30, v8
    v_and_b32 v35, v30, v9
    v_mfma_f32_16x16x32_bf16 v[16:19], v[116:119], v[36:39], v[16:19]
    v_and_b32 v36, v31, v6
    v_and_b32 v37, v31, v7
    v_and_b32 v38, v31, v8
    v_and_b32 v39, v31, v9
    v_mfma_f32_16x16x32_bf16 v[16:19], v[120:123], v[32:35], v[16:19]
    s_nop 0
    v_mfma_f32_16x16x32_bf16 v[16:19], v[124:127], v[36:39], v[16:19]
    buffer_load_dwordx4 v[112:115], v11, s[44:47], s65 offen offset:0 nt
    buffer_load_dwordx4 v[116:119], v11, s[44:47], s65 offen offset:256 nt
    buffer_load_dwordx4 v[120:123], v11, s[44:47], s65 offen offset:512 nt
    buffer_load_dwordx4 v[124:127], v11, s[44:47], s65 offen offset:768 nt
    s_add_u32 s65, s65, 16384
    s_sub_u32 s62, s62, 1
    s_cmp_lg_u32 s62, 6
    s_cbranch_scc1 L_trig_5
    v_mov_b32 v58, 10500
    v_mov_b32 v59, 1
    ds_write_b32 v58, v59
L_trig_5:
    s_cmp_eq_u32 s62, 0
    s_cbranch_scc1 F_loop_exit
    s_waitcnt vmcnt(28)
    v_mfma_f32_16x16x32_bf16 v[20:23], v[128:131], v[40:43], 0
    v_mfma_f32_16x16x32_bf16 v[20:23], v[132:135], v[44:47], v[20:23]
    v_mfma_f32_16x16x32_bf16 v[20:23], v[136:139], v[48:51], v[20:23]
    v_mfma_f32_16x16x32_bf16 v[20:23], v[140:143], v[52:55], v[20:23]
    buffer_load_dwordx4 v[128:131], v10, s[40:43], s64 offen offset:0 nt
    buffer_load_dwordx4 v[132:135], v10, s[40:43], s64 offen offset:64 nt
    buffer_load_dwordx4 v[136:139], v10, s[40:43], s64 offen offset:128 nt
    buffer_load_dwordx4 v[140:143], v10, s[40:43], s64 offen offset:192 nt
    s_add_u32 s64, s64, 16384
    s_nop 2
    v_cvt_pk_bf16_f32 v56, v20, v21
    v_cvt_pk_bf16_f32 v57, v22, v23
    v_lshlrev_b32 v24, 16, v56
    v_and_b32 v25, 0xffff0000, v56
    v_lshlrev_b32 v26, 16, v57
    v_and_b32 v27, 0xffff0000, v57
    v_mul_f32 v24, s60, v24
    v_mul_f32 v25, s60, v25
    v_mul_f32 v26, s60, v26
    v_mul_f32 v27, s60, v27
    v_cvt_pk_bf16_f32 v56, v24, v25
    v_cvt_pk_bf16_f32 v57, v26, v27
    v_lshlrev_b32 v24, 16, v56
    v_and_b32 v25, 0xffff0000, v56
    v_lshlrev_b32 v26, 16, v57
    v_and_b32 v27, 0xffff0000, v57
    v_max3_f32 v56, v24, v25, v26
    v_max3_f32 v56, v56, v27, v12
    v_mov_b32 v57, v56
    s_nop 1
    v_permlane16_swap_b32 v56, v57
    s_nop 1
    v_max_f32 v56, v56, v57
    v_mov_b32 v57, v56
    s_nop 1
    v_permlane32_swap_b32 v56, v57
    s_nop 1
    v_max_f32 v56, v56, v57
    v_sub_f32 v57, v12, v56
    v_mul_f32 v57, s61, v57
    v_exp_f32 v57, v57
    v_mov_b32 v12, v56
    v_mul_f32 v58, s61, v56
    v_fma_f32 v28, v24, s61, -v58
    v_fma_f32 v29, v25, s61, -v58
    v_fma_f32 v30, v26, s61, -v58
    v_fma_f32 v31, v27, s61, -v58
    v_exp_f32 v28, v28
    v_exp_f32 v29, v29
    v_exp_f32 v30, v30
    v_exp_f32 v31, v31
    v_mul_f32 v16, v16, v57
    v_mul_f32 v17, v17, v57
    v_mul_f32 v18, v18, v57
    v_mul_f32 v19, v19, v57
    v_fma_f32 v13, v13, v57, v28
    v_add_f32 v13, v13, v29
    v_add_f32 v13, v13, v30
    v_add_f32 v13, v13, v31
    v_cvt_pk_bf16_f32 v28, v28, v28
    v_cvt_pk_bf16_f32 v29, v29, v29
    v_cvt_pk_bf16_f32 v30, v30, v30
    v_cvt_pk_bf16_f32 v31, v31, v31
    s_waitcnt vmcnt(28)
    v_and_b32 v32, v28, v6
    v_and_b32 v33, v28, v7
    v_and_b32 v34, v28, v8
    v_and_b32 v35, v28, v9
    v_and_b32 v36, v29, v6
    v_and_b32 v37, v29, v7
    v_and_b32 v38, v29, v8
    v_and_b32 v39, v29, v9
    v_mfma_f32_16x16x32_bf16 v[16:19], v[144:147], v[32:35], v[16:19]
    v_and_b32 v32, v30, v6
    v_and_b32 v33, v30, v7
    v_and_b32 v34, v30, v8
    v_and_b32 v35, v30, v9
    v_mfma_f32_16x16x32_bf16 v[16:19], v[148:151], v[36:39], v[16:19]
    v_and_b32 v36, v31, v6
    v_and_b32 v37, v31, v7
    v_and_b32 v38, v31, v8
    v_and_b32 v39, v31, v9
    v_mfma_f32_16x16x32_bf16 v[16:19], v[152:155], v[32:35], v[16:19]
    s_nop 0
    v_mfma_f32_16x16x32_bf16 v[16:19], v[156:159], v[36:39], v[16:19]
    buffer_load_dwordx4 v[144:147], v11, s[44:47], s65 offen offset:0 nt
    buffer_load_dwordx4 v[148:151], v11, s[44:47], s65 offen offset:256 nt
    buffer_load_dwordx4 v[152:155], v11, s[44:47], s65 offen offset:512 nt
    buffer_load_dwordx4 v[156:159], v11, s[44:47], s65 offen offset:768 nt
    s_add_u32 s65, s65, 16384
    s_sub_u32 s62, s62, 1
    s_cmp_lg_u32 s62, 6
    s_cbranch_scc1 L_trig_6
    v_mov_b32 v58, 10500
    v_mov_b32 v59, 1
    ds_write_b32 v58, v59
L_trig_6:
    s_cmp_eq_u32 s62, 0
    s_cbranch_scc1 F_loop_exit
    s_waitcnt vmcnt(28)
    v_mfma_f32_16x16x32_bf16 v[20:23], v[160:163], v[40:43], 0
    v_mfma_f32_16x16x32_bf16 v[20:23], v[164:167], v[44:47], v[20:23]
    v_mfma_f32_16x16x32_bf16 v[20:23], v[168:171], v[48:51], v[20:23]
    v_mfma_f32_16x16x32_bf16 v[20:23], v[172:175], v[52:55], v[20:23]
    buffer_load_dwordx4 v[160:163], v10, s[40:43], s64 offen offset:0 nt
    buffer_load_dwordx4 v[164:167], v10, s[40:43], s64 offen offset:64 nt
    buffer_load_dwordx4 v[168:171], v10, s[40:43], s64 offen offset:128 nt
    buffer_load_dwordx4 v[172:175], v10, s[40:43], s64 offen offset:192 nt
    s_add_u32 s64, s64, 16384
    s_nop 2
    v_cvt_pk_bf16_f32 v56, v20, v21
    v_cvt_pk_bf16_f32 v57, v22, v23
    v_lshlrev_b32 v24, 16, v56
    v_and_b32 v25, 0xffff0000, v56
    v_lshlrev_b32 v26, 16, v57
    v_and_b32 v27, 0xffff0000, v57
    v_mul_f32 v24, s60, v24
    v_mul_f32 v25, s60, v25
    v_mul_f32 v26, s60, v26
    v_mul_f32 v27, s60, v27
    v_cvt_pk_bf16_f32 v56, v24, v25
    v_cvt_pk_bf16_f32 v57, v26, v27
    v_lshlrev_b32 v24, 16, v56
    v_and_b32 v25, 0xffff0000, v56
    v_lshlrev_b32 v26, 16, v57
    v_and_b32 v27, 0xffff0000, v57
    v_max3_f32 v56, v24, v25, v26
    v_max3_f32 v56, v56, v27, v12
    v_mov_b32 v57, v56
    s_nop 1
    v_permlane16_swap_b32 v56, v57
    s_nop 1
    v_max_f32 v56, v56, v57
    v_mov_b32 v57, v56
    s_nop 1
    v_permlane32_swap_b32 v56, v57
    s_nop 1
    v_max_f32 v56, v56, v57
    v_sub_f32 v57, v12, v56
    v_mul_f32 v57, s61, v57
    v_exp_f32 v57, v57
    v_mov_b32 v12, v56
    v_mul_f32 v58, s61, v56
    v_fma_f32 v28, v24, s61, -v58
    v_fma_f32 v29, v25, s61, -v58
    v_fma_f32 v30, v26, s61, -v58
    v_fma_f32 v31, v27, s61, -v58
    v_exp_f32 v28, v28
    v_exp_f32 v29, v29
    v_exp_f32 v30, v30
    v_exp_f32 v31, v31
    v_mul_f32 v16, v16, v57
    v_mul_f32 v17, v17, v57
    v_mul_f32 v18, v18, v57
    v_mul_f32 v19, v19, v57
    v_fma_f32 v13, v13, v57, v28
    v_add_f32 v13, v13, v29
    v_add_f32 v13, v13, v30
    v_add_f32 v13, v13, v31
    v_cvt_pk_bf16_f32 v28, v28, v28
    v_cvt_pk_bf16_f32 v29, v29, v29
    v_cvt_pk_bf16_f32 v30, v30, v30
    v_cvt_pk_bf16_f32 v31, v31, v31
    s_waitcnt vmcnt(28)
    v_and_b32 v32, v28, v6
    v_and_b32 v33, v28, v7
    v_and_b32 v34, v28, v8
    v_and_b32 v35, v28, v9
    v_and_b32 v36, v29, v6
    v_and_b32 v37, v29, v7
    v_and_b32 v38, v29, v8
    v_and_b32 v39, v29, v9
    v_mfma_f32_16x16x32_bf16 v[16:19], v[176:179], v[32:35], v[16:19]
    v_and_b32 v32, v30, v6
    v_and_b32 v33, v30, v7
    v_and_b32 v34, v30, v8
    v_and_b32 v35, v30, v9
    v_mfma_f32_16x16x32_bf16 v[16:19], v[180:183], v[36:39], v[16:19]
    v_and_b32 v36, v31, v6
    v_and_b32 v37, v31, v7
    v_and_b32 v38, v31, v8
    v_and_b32 v39, v31, v9
    v_mfma_f32_16x16x32_bf16 v[16:19], v[184:187], v[32:35], v[16:19]
    s_nop 0
    v_mfma_f32_16x16x32_bf16 v[16:19], v[188:191], v[36:39], v[16:19]
    buffer_load_dwordx4 v[176:179], v11, s[44:47], s65 offen offset:0 nt
    buffer_load_dwordx4 v[180:183], v11, s[44:47], s65 offen offset:256 nt
    buffer_load_dwordx4 v[184:187], v11, s[44:47], s65 offen offset:512 nt
    buffer_load_dwordx4 v[188:191], v11, s[44:47], s65 offen offset:768 nt
    s_add_u32 s65, s65, 16384
    s_sub_u32 s62, s62, 1
    s_cmp_lg_u32 s62, 6
    s_cbranch_scc1 L_trig_7
    v_mov_b32 v58, 10500
    v_mov_b32 v59, 1
    ds_write_b32 v58, v59
L_trig_7:
    s_cmp_lg_u32 s62, 0
    s_cbranch_scc1 F_loop
F_loop_exit:
    v_mov_b32 v56, v13
    s_nop 1
    v_permlane16_swap_b32 v13, v56
    s_nop 1
    v_add_f32 v13, v13, v56
    v_mov_b32 v56, v13
    s_nop 1
    v_permlane32_swap_b32 v13, v56
    s_nop 1
    v_add_f32 v13, v13, v56
    v_lshlrev_b32 v56, 4, v1
    s_lshl_b32 s60, s3, 10
    v_add_u32 v56, s60, v56
    s_nop 3
    ds_write_b128 v56, v[16:19] offset:10560
    v_and_b32 v57, 8, v1
    s_lshl_b32 s60, s3, 4
    v_add_u32 v57, s60, v57
    s_mov_b64 exec, 0x101
    ds_write_b64 v57, v[12:13] offset:14656
    s_mov_b64 exec, -1
    s_waitcnt lgkmcnt(0)
    s_barrier
    s_cmp_lg_u32 s33, 1
    s_cbranch_scc1 F_end
    s_branch F_s4gather
F_helper:
    s_setprio 3
    v_lshrrev_b32 v10, 2, v3
    v_lshl_add_u32 v11, v2, 3, v10
    v_lshlrev_b32 v60, 7, v11
    v_and_b32 v10, 2, v10
    v_and_b32 v11, 1, v2
    v_lshl_or_b32 v10, v11, 2, v10
    v_bfe_u32 v11, v3, 1, 1
    s_lshl_b32 s60, s34, 1
    v_add_u32 v11, s60, v11
    v_xor_b32 v10, v10, v11
    v_lshl_add_u32 v60, v10, 4, v60
    v_and_b32 v10, 1, v3
    v_lshl_add_u32 v60, v10, 3, v60
    v_and_b32 v61, 7, v3
    v_and_b32 v10, 1, v2
    v_lshlrev_b32 v10, 2, v10
    v_lshrrev_b32 v11, 1, v2
    v_lshl_add_u32 v10, v11, 1, v10
    v_and_b32 v11, 1, v3
    v_add_u32 v10, v10, v11
    v_lshrrev_b32 v11, 1, v3
    s_lshl_b32 s60, s34, 3
    v_add_u32 v11, s60, v11
    v_lshlrev_b32 v58, 9, v10
    v_lshl_add_u32 v58, v11, 4, v58
    s_mov_b32 s60, 53248
    v_mul_lo_u32 v59, v10, s60
    v_lshl_add_u32 v59, v11, 3, v59
    s_mul_i32 s78, s77, 9
    s_sub_u32 s78, s95, s78
    s_mul_i32 s60, s3, 544
    v_lshlrev_b32 v15, 3, v1
    v_add_u32 v15, s60, v15
    s_waitcnt lgkmcnt(0)
    s_load_dword s28, s[26:27], 0
    s_load_dwordx2 s[100:101], s[24:25], 0
    s_barrier
    s_mov_b32 s36, s26
    s_mov_b32 s37, s27
    s_mov_b32 s38, 3145728
    s_mov_b32 s39, 0x00020000
    s_mov_b32 s75, 0
    s_cmp_eq_u32 s33, 2
    s_cbranch_scc1 F_noS1
    s_mul_i32 s67, s34, 2304
    s_add_u32 s52, s4, s67
    s_addc_u32 s53, s5, 0
    s_mov_b32 s54, 2304
    s_mov_b32 s55, 0x00020000
    v_and_b32 v12, 31, v1
    v_lshlrev_b32 v12, 2, v12
    v_lshrrev_b32 v11, 5, v1
    v_mul_u32_u24 v11, 1152, v11
    v_add_u32 v12, v12, v11
    buffer_load_dword v100, v12, s[52:55], 0 offen offset:0
    buffer_load_dword v101, v12, s[52:55], 0 offen offset:128
    buffer_load_dword v102, v12, s[52:55], 0 offen offset:256
    buffer_load_dword v103, v12, s[52:55], 0 offen offset:384
    buffer_load_dword v104, v12, s[52:55], 0 offen offset:512
    buffer_load_dword v105, v12, s[52:55], 0 offen offset:640
    buffer_load_dword v106, v12, s[52:55], 0 offen offset:768
    buffer_load_dword v107, v12, s[52:55], 0 offen offset:896
    buffer_load_dword v108, v12, s[52:55], 0 offen offset:1024
    s_cmp_lg_u32 s33, 0
    s_cbranch_scc1 F_no_q_dma
    s_mov_b32 s79, s95
    s_call_b64 s[98:99], SUB_S1DMA
    s_barrier
    s_waitcnt vmcnt(18)
    s_branch F_ln
F_no_q_dma:
    s_movk_i32 s61, 1152
    v_lshrrev_b32 v10, 3, v1
    v_mul_lo_u32 v10, v10, s61
    v_bfe_u32 v11, v1, 4, 1
    v_lshlrev_b32 v11, 1, v11
    v_and_b32 v12, 7, v1
    v_xor_b32 v11, v11, v12
    v_xor_b32 v12, 4, v11
    v_lshl_add_u32 v14, v12, 4, v10
    v_lshl_add_u32 v10, v11, 4, v10
    s_lshl_b32 s60, s77, 2
    s_add_u32 s60, s60, s34
    s_mul_i32 s60, s60, 73728
    s_lshl_b32 s61, s78, 7
    s_add_u32 s60, s60, s61
    s_add_u32 s48, s12, s60
    s_addc_u32 s49, s13, 0
    s_sub_u32 s50, 73728, s61
    s_mov_b32 s51, 0x00020000
    s_lshl_b32 s62, s34, 13
    s_add_u32 s62, s62, 95232
    s_mov_b32 s60, 0
    s_movk_i32 s61, 9216
    s_mov_b32 s63, 4
    s_call_b64 s[96:97], SUB_WD
    s_barrier
    s_waitcnt vmcnt(8)
F_ln:
    s_waitcnt lgkmcnt(0)
    s_add_u32 s28, s28, 1
    s_and_b32 s100, s100, 0xffffff00
    s_lshr_b32 s101, s101, 4
    s_mul_hi_u32 s101, s101, 0x4ec4ec4f
    s_lshr_b32 s101, s101, 2
    s_mul_i32 s101, s101, 208
    v_lshlrev_b32 v110, 16, v100
    v_and_b32 v111, 0xffff0000, v100
    v_lshlrev_b32 v112, 16, v101
    v_and_b32 v113, 0xffff0000, v101
    v_lshlrev_b32 v114, 16, v102
    v_and_b32 v115, 0xffff0000, v102
    v_lshlrev_b32 v116, 16, v103
    v_and_b32 v117, 0xffff0000, v103
    v_lshlrev_b32 v118, 16, v104
    v_and_b32 v119, 0xffff0000, v104
    v_lshlrev_b32 v120, 16, v105
    v_and_b32 v121, 0xffff0000, v105
    v_lshlrev_b32 v122, 16, v106
    v_and_b32 v123, 0xffff0000, v106
    v_lshlrev_b32 v124, 16, v107
    v_and_b32 v125, 0xffff0000, v107
    v_lshlrev_b32 v126, 16, v108
    v_and_b32 v127, 0xffff0000, v108
    v_add_f32 v32, v110, v111
    v_add_f32 v33, v112, v113
    v_add_f32 v34, v114, v115
    v_add_f32 v32, v32, v116
    v_add_f32 v33, v33, v117
    v_add_f32 v34, v34, v118
    v_add_f32 v32, v32, v119
    v_add_f32 v33, v33, v120
    v_add_f32 v34, v34, v121
    v_add_f32 v32, v32, v122
    v_add_f32 v33, v33, v123
    v_add_f32 v34, v34, v124
    v_add_f32 v32, v32, v125
    v_add_f32 v33, v33, v126
    v_add_f32 v34, v34, v127
    v_add_f32 v32, v32, v33
    v_add_f32 v32, v32, v34
    s_nop 1
    v_add_f32_dpp v32, v32, v32 row_ror:8 row_mask:0xf bank_mask:0xf
    s_nop 1
    v_add_f32_dpp v32, v32, v32 row_ror:4 row_mask:0xf bank_mask:0xf
    s_nop 1
    v_add_f32_dpp v32, v32, v32 row_ror:2 row_mask:0xf bank_mask:0xf
    s_nop 1
    v_add_f32_dpp v32, v32, v32 row_ror:1 row_mask:0xf bank_mask:0xf
    v_mov_b32 v33, v32
    s_nop 1
    v_permlane16_swap_b32 v32, v33
    s_nop 1
    v_add_f32 v32, v32, v33
    v_mul_f32 v32, 0x3ae38e39, v32
    v_sub_f32 v34, v110, v32
    v_sub_f32 v35, v111, v32
    v_mul_f32 v33, v34, v34
    v_mul_f32 v36, v35, v35
    v_sub_f32 v34, v112, v32
    v_sub_f32 v35, v113, v32
    v_fmac_f32 v33, v34, v34
    v_fmac_f32 v36, v35, v35
    v_sub_f32 v34, v114, v32
    v_sub_f32 v35, v115, v32
    v_fmac_f32 v33, v34, v34
    v_fmac_f32 v36, v35, v35
    v_sub_f32 v34, v116, v32
    v_sub_f32 v35, v117, v32
    v_fmac_f32 v33, v34, v34
    v_fmac_f32 v36, v35, v35
    v_sub_f32 v34, v118, v32
    v_sub_f32 v35, v119, v32
    v_fmac_f32 v33, v34, v34
    v_fmac_f32 v36, v35, v35
    v_sub_f32 v34, v120, v32
    v_sub_f32 v35, v121, v32
    v_fmac_f32 v33, v34, v34
    v_fmac_f32 v36, v35, v35
    v_sub_f32 v34, v122, v32
    v_sub_f32 v35, v123, v32
    v_fmac_f32 v33, v34, v34
    v_fmac_f32 v36, v35, v35
    v_sub_f32 v34, v124, v32
    v_sub_f32 v35, v125, v32
    v_fmac_f32 v33, v34, v34
    v_fmac_f32 v36, v35, v35
    v_sub_f32 v34, v126, v32
    v_sub_f32 v35, v127, v32
    v_fmac_f32 v33, v34, v34
    v_fmac_f32 v36, v35, v35
    v_add_f32 v33, v33, v36
    s_nop 1
    v_add_f32_dpp v33, v33, v33 row_ror:8 row_mask:0xf bank_mask:0xf
    s_nop 1
    v_add_f32_dpp v33, v33, v33 row_ror:4 row_mask:0xf bank_mask:0xf
    s_nop 1
    v_add_f32_dpp v33, v33, v33 row_ror:2 row_mask:0xf bank_mask:0xf
    s_nop 1
    v_add_f32_dpp v33, v33, v33 row_ror:1 row_mask:0xf bank_mask:0xf
    v_mov_b32 v34, v33
    s_nop 1
    v_permlane16_swap_b32 v33, v34
    s_nop 1
    v_add_f32 v33, v33, v34
    v_mul_f32 v33, 0x3ae38e39, v33
    v_cvt_pk_bf16_f32 v34, v32, v33
    v_lshlrev_b32 v32, 16, v34
    v_and_b32 v33, 0xffff0000, v34
    v_add_f32 v33, 0x3727c5ac, v33
    v_cvt_pk_bf16_f32 v33, v33, v33
    v_and_b32 v33, 0xffff0000, v33
    v_sqrt_f32 v33, v33
    s_nop 0
    v_cvt_pk_bf16_f32 v33, v33, v33
    v_and_b32 v33, 0xffff0000, v33
    v_rcp_f32 v34, v33
    s_nop 0
    v_sub_f32 v110, v110, v32
    v_sub_f32 v111, v111, v32
    v_cvt_pk_bf16_f32 v35, v110, v111
    v_lshlrev_b32 v110, 16, v35
    v_and_b32 v111, 0xffff0000, v35
    v_mul_f32 v36, v110, v34
    v_mul_f32 v37, v111, v34
    v_fma_f32 v110, -v36, v33, v110
    v_fma_f32 v111, -v37, v33, v111
    v_fma_f32 v36, v110, v34, v36
    v_fma_f32 v37, v111, v34, v37
    v_cvt_pk_bf16_f32 v100, v36, v37
    v_sub_f32 v112, v112, v32
    v_sub_f32 v113, v113, v32
    v_cvt_pk_bf16_f32 v35, v112, v113
    v_lshlrev_b32 v112, 16, v35
    v_and_b32 v113, 0xffff0000, v35
    v_mul_f32 v36, v112, v34
    v_mul_f32 v37, v113, v34
    v_fma_f32 v112, -v36, v33, v112
    v_fma_f32 v113, -v37, v33, v113
    v_fma_f32 v36, v112, v34, v36
    v_fma_f32 v37, v113, v34, v37
    v_cvt_pk_bf16_f32 v101, v36, v37
    v_sub_f32 v114, v114, v32
    v_sub_f32 v115, v115, v32
    v_cvt_pk_bf16_f32 v35, v114, v115
    v_lshlrev_b32 v114, 16, v35
    v_and_b32 v115, 0xffff0000, v35
    v_mul_f32 v36, v114, v34
    v_mul_f32 v37, v115, v34
    v_fma_f32 v114, -v36, v33, v114
    v_fma_f32 v115, -v37, v33, v115
    v_fma_f32 v36, v114, v34, v36
    v_fma_f32 v37, v115, v34, v37
    v_cvt_pk_bf16_f32 v102, v36, v37
    v_sub_f32 v116, v116, v32
    v_sub_f32 v117, v117, v32
    v_cvt_pk_bf16_f32 v35, v116, v117
    v_lshlrev_b32 v116, 16, v35
    v_and_b32 v117, 0xffff0000, v35
    v_mul_f32 v36, v116, v34
    v_mul_f32 v37, v117, v34
    v_fma_f32 v116, -v36, v33, v116
    v_fma_f32 v117, -v37, v33, v117
    v_fma_f32 v36, v116, v34, v36
    v_fma_f32 v37, v117, v34, v37
    v_cvt_pk_bf16_f32 v103, v36, v37
    v_sub_f32 v118, v118, v32
    v_sub_f32 v119, v119, v32
    v_cvt_pk_bf16_f32 v35, v118, v119
    v_lshlrev_b32 v118, 16, v35
    v_and_b32 v119, 0xffff0000, v35
    v_mul_f32 v36, v118, v34
    v_mul_f32 v37, v119, v34
    v_fma_f32 v118, -v36, v33, v118
    v_fma_f32 v119, -v37, v33, v119
    v_fma_f32 v36, v118, v34, v36
    v_fma_f32 v37, v119, v34, v37
    v_cvt_pk_bf16_f32 v104, v36, v37
    v_sub_f32 v120, v120, v32
    v_sub_f32 v121, v121, v32
    v_cvt_pk_bf16_f32 v35, v120, v121
    v_lshlrev_b32 v120, 16, v35
    v_and_b32 v121, 0xffff0000, v35
    v_mul_f32 v36, v120, v34
    v_mul_f32 v37, v121, v34
    v_fma_f32 v120, -v36, v33, v120
    v_fma_f32 v121, -v37, v33, v121
    v_fma_f32 v36, v120, v34, v36
    v_fma_f32 v37, v121, v34, v37
    v_cvt_pk_bf16_f32 v105, v36, v37
    v_sub_f32 v122, v122, v32
    v_sub_f32 v123, v123, v32
    v_cvt_pk_bf16_f32 v35, v122, v123
    v_lshlrev_b32 v122, 16, v35
    v_and_b32 v123, 0xffff0000, v35
    v_mul_f32 v36, v122, v34
    v_mul_f32 v37, v123, v34
    v_fma_f32 v122, -v36, v33, v122
    v_fma_f32 v123, -v37, v33, v123
    v_fma_f32 v36, v122, v34, v36
    v_fma_f32 v37, v123, v34, v37
    v_cvt_pk_bf16_f32 v106, v36, v37
    v_sub_f32 v124, v124, v32
    v_sub_f32 v125, v125, v32
    v_cvt_pk_bf16_f32 v35, v124, v125
    v_lshlrev_b32 v124, 16, v35
    v_and_b32 v125, 0xffff0000, v35
    v_mul_f32 v36, v124, v34
    v_mul_f32 v37, v125, v34
    v_fma_f32 v124, -v36, v33, v124
    v_fma_f32 v125, -v37, v33, v125
    v_fma_f32 v36, v124, v34, v36
    v_fma_f32 v37, v125, v34, v37
    v_cvt_pk_bf16_f32 v107, v36, v37
    v_sub_f32 v126, v126, v32
    v_sub_f32 v127, v127, v32
    v_cvt_pk_bf16_f32 v35, v126, v127
    v_lshlrev_b32 v126, 16, v35
    v_and_b32 v127, 0xffff0000, v35
    v_mul_f32 v36, v126, v34
    v_mul_f32 v37, v127, v34
    v_fma_f32 v126, -v36, v33, v126
    v_fma_f32 v127, -v37, v33, v127
    v_fma_f32 v36, v126, v34, v36
    v_fma_f32 v37, v127, v34, v37
    v_cvt_pk_bf16_f32 v108, v36, v37
    s_mul_i32 s67, s34, 2624
    v_and_b32 v11, 31, v1
    v_lshlrev_b32 v11, 2, v11
    v_lshrrev_b32 v12, 5, v1
    v_mul_u32_u24 v12, 1312, v12
    v_add3_u32 v11, v11, v12, s67
    ds_write_b32 v11, v100 offset:0
    ds_write_b32 v11, v101 offset:128
    ds_write_b32 v11, v102 offset:256
    ds_write_b32 v11, v103 offset:384
    ds_write_b32 v11, v104 offset:512
    ds_write_b32 v11, v105 offset:640
    ds_write_b32 v11, v106 offset:768
    ds_write_b32 v11, v107 offset:896
    ds_write_b32 v11, v108 offset:1024
    s_cmp_lg_u32 s33, 0
    s_cbranch_scc1 F_h2
    s_call_b64 s[98:99], SUB_S1C
    s_cmp_lt_u32 s95, 46
    s_cbranch_scc1 F_h2
    s_sub_u32 s60, s95, 46
    s_mul_i32 s70, s60, 57
    s_lshr_b32 s70, s70, 9
    s_mul_i32 s61, s70, 9
    s_sub_u32 s71, s60, s61
    s_add_u32 s70, s70, 16
    s_movk_i32 s61, 1152
    v_lshrrev_b32 v10, 3, v1
    v_mul_lo_u32 v10, v10, s61
    v_bfe_u32 v11, v1, 4, 1
    v_lshlrev_b32 v11, 1, v11
    v_and_b32 v12, 7, v1
    v_xor_b32 v11, v11, v12
    v_xor_b32 v12, 4, v11
    v_lshl_add_u32 v14, v12, 4, v10
    v_lshl_add_u32 v10, v11, 4, v10
    s_lshl_b32 s60, s70, 2
    s_add_u32 s60, s60, s34
    s_mul_i32 s60, s60, 73728
    s_lshl_b32 s61, s71, 7
    s_add_u32 s60, s60, s61
    s_add_u32 s48, s20, s60
    s_addc_u32 s49, s21, 0
    s_sub_u32 s50, 73728, s61
    s_mov_b32 s51, 0x00020000
    s_lshl_b32 s62, s34, 13
    s_add_u32 s62, s62, 95232
    s_mov_b32 s60, 0
    s_movk_i32 s61, 9216
    s_mov_b32 s63, 4
    s_call_b64 s[96:97], SUB_WD
    s_branch F_h2
F_noS1:
    s_mov_b32 s60, s95
    s_mul_i32 s70, s60, 171
    s_lshr_b32 s70, s70, 9
    s_mul_i32 s61, s70, 3
    s_sub_u32 s71, s60, s61
    s_mul_i32 s71, s71, 3
    s_movk_i32 s61, 1152
    v_lshrrev_b32 v10, 3, v1
    v_mul_lo_u32 v10, v10, s61
    v_bfe_u32 v11, v1, 4, 1
    v_lshlrev_b32 v11, 1, v11
    v_and_b32 v12, 7, v1
    v_xor_b32 v11, v11, v12
    v_xor_b32 v12, 4, v11
    v_lshl_add_u32 v14, v12, 4, v10
    v_lshl_add_u32 v10, v11, 4, v10
    s_lshl_b32 s60, s70, 2
    s_add_u32 s60, s60, s34
    s_mul_i32 s60, s60, 73728
    s_lshl_b32 s61, s71, 7
    s_add_u32 s60, s60, s61
    s_add_u32 s48, s20, s60
    s_addc_u32 s49, s21, 0
    s_sub_u32 s50, 73728, s61
    s_mov_b32 s51, 0x00020000
    s_lshl_b32 s62, s34, 13
    s_add_u32 s62, s62, 21504
    s_mov_b32 s60, 0
    s_movk_i32 s61, 9216
    s_mov_b32 s63, 4
    s_call_b64 s[96:97], SUB_WD
    s_lshl_b32 s62, s34, 13
    s_add_u32 s62, s62, 54272
    s_mov_b32 s60, 128
    s_movk_i32 s61, 9216
    s_mov_b32 s63, 4
    s_call_b64 s[96:97], SUB_WD
    s_lshl_b32 s62, s34, 13
    s_add_u32 s62, s62, 87040
    s_mov_b32 s60, 256
    s_movk_i32 s61, 9216
    s_mov_b32 s63, 4
    s_call_b64 s[96:97], SUB_WD
    s_barrier
    s_waitcnt lgkmcnt(0)
    s_add_u32 s28, s28, 1
    s_and_b32 s100, s100, 0xffffff00
    s_lshr_b32 s101, s101, 4
    s_mul_hi_u32 s101, s101, 0x4ec4ec4f
    s_lshr_b32 s101, s101, 2
    s_mul_i32 s101, s101, 208
    s_mov_b32 s79, 255
    s_branch F_noclaim
F_h2:
    s_cmp_lg_u32 s3, 4
    s_cbranch_scc1 F_cl_wait
    v_mov_b32 v36, 10500
    s_mov_b32 s66, 200000
F_cl_spin:
    ds_read_b32 v37, v36
    s_waitcnt lgkmcnt(0)
    v_readfirstlane_b32 s65, v37
    s_nop 3
    s_cmp_lg_u32 s65, 0
    s_cbranch_scc1 F_cl_go
    s_sleep 8
    s_sub_u32 s66, s66, 1
    s_cmp_lg_u32 s66, 0
    s_cbranch_scc1 F_cl_spin
F_cl_go:
    s_mov_b32 s52, s24
    s_mov_b32 s53, s25
    s_mov_b32 s54, 256
    s_mov_b32 s55, 0x00020000
    v_mov_b32 v37, 1
    v_mov_b32 v38, 4
    s_mov_b64 exec, 1
    buffer_atomic_add v37, v38, s[52:55], 0 offen sc0 sc1
    s_waitcnt vmcnt(0)
    v_subrev_u32 v37, s101, v37
    v_add_u32 v37, 1, v37
    v_mov_b32 v36, 10504
    ds_write_b32 v36, v37
    s_mov_b64 exec, -1
F_cl_wait:
    v_mov_b32 v36, 10504
    s_mov_b32 s66, 200000
F_cl_spin2:
    ds_read_b32 v37, v36
    s_waitcnt lgkmcnt(0)
    v_readfirstlane_b32 s65, v37
    s_nop 3
    s_cmp_lg_u32 s65, 0
    s_cbranch_scc1 F_cl_got
    s_sleep 8
    s_sub_u32 s66, s66, 1
    s_cmp_lg_u32 s66, 0
    s_cbranch_scc1 F_cl_spin2
    s_mov_b32 s65, 1000
F_cl_got:
    s_sub_u32 s65, s65, 1
    s_mov_b32 s79, 255
    s_cmp_ge_u32 s65, 144
    s_cbranch_scc1 F_noclaim
    s_add_u32 s79, s65, 64
    s_call_b64 s[98:99], SUB_S1DMA
    s_call_b64 s[98:99], SUB_S1C
    s_mov_b32 s79, 255
F_noclaim:
    v_lshrrev_b32 v11, 5, v1
    v_mul_u32_u24 v11, 36864, v11
    v_and_b32 v12, 31, v1
    v_lshl_add_u32 v11, v12, 4, v11
    v_lshlrev_b32 v13, 2, v12
    s_mov_b32 s81, 0
    s_mov_b32 s82, 0
    s_mov_b32 s92, 255
    s_cmp_eq_u32 s33, 2
    s_cselect_b32 s92, s95, s92
    s_add_u32 s60, s95, 48
    s_cmp_lt_u32 s95, 24
    s_cselect_b32 s60, s60, 255
    s_cmp_eq_u32 s33, 0
    s_cselect_b32 s92, s60, s92
    s_cmp_lg_u32 s3, 4
    s_cselect_b32 s92, 255, s92
    s_cmp_ge_u32 s92, 72
    s_cbranch_scc1 F_fin_nopre
    s_mov_b32 s60, s92
    s_mul_i32 s93, s60, 57
    s_lshr_b32 s93, s93, 9
    s_mul_i32 s80, s93, 9
    s_sub_u32 s80, s60, s80
    s_lshl_b32 s81, s80, 12
    s_lshl_b32 s61, s93, 9
    s_add_u32 s81, s81, s61
    s_add_u32 s81, s81, 1179648
    s_mul_i32 s60, s93, 1152
    s_lshl_b32 s61, s80, 7
    s_add_u32 s82, s60, s61
F_fin_nopre:
    s_lshr_b32 s85, s34, 1
    s_and_b32 s86, s34, 1
    v_lshrrev_b32 v52, 5, v1
    s_lshl_b32 s62, s86, 1
    v_add_u32 v52, s62, v52
    v_lshlrev_b32 v52, 8, v52
    v_and_b32 v53, 7, v1
    v_lshl_add_u32 v52, v53, 4, v52
    v_bfe_u32 v53, v1, 3, 2
    v_lshl_add_u32 v52, v53, 2, v52
    s_lshl_b32 s62, s85, 7
    v_add_u32 v52, s62, v52
    s_lshl_b32 s62, s85, 3
    v_mov_b32 v53, s62
    s_mul_i32 s87, s32, 2304
    s_add_u32 s87, s87, 524288
    s_lshl_b32 s88, s34, 9
    s_add_u32 s88, s88, s87
    s_lshl_b32 s89, s85, 4
    s_add_u32 s89, s89, s87
    s_add_u32 s89, s89, 2048
    v_lshlrev_b32 v54, 3, v1
    v_mov_b32 v55, 0
    s_mov_b32 s56, s22
    s_mov_b32 s57, s23
    s_mov_b32 s58, 9216
    s_mov_b32 s59, 0x00020000
    s_waitcnt lgkmcnt(0)
    s_barrier
    ds_read_b32 v16, v52 offset:10560
    ds_read_b32 v17, v52 offset:11584
    ds_read_b32 v18, v52 offset:12608
    ds_read_b32 v19, v52 offset:13632
    ds_read_b64 v[20:21], v53 offset:14656
    ds_read_b64 v[22:23], v53 offset:14672
    ds_read_b64 v[24:25], v53 offset:14688
    ds_read_b64 v[26:27], v53 offset:14704
    s_waitcnt lgkmcnt(0)
    v_max3_f32 v28, v20, v22, v24
    v_max_f32 v28, v28, v26
    s_mov_b32 s63, 0x3fb8aa3b
    v_sub_f32 v20, v20, v28
    v_mul_f32 v20, s63, v20
    v_exp_f32 v20, v20
    v_sub_f32 v22, v22, v28
    v_mul_f32 v22, s63, v22
    v_exp_f32 v22, v22
    v_sub_f32 v24, v24, v28
    v_mul_f32 v24, s63, v24
    v_exp_f32 v24, v24
    v_sub_f32 v26, v26, v28
    v_mul_f32 v26, s63, v26
    v_exp_f32 v26, v26
    s_nop 0
    v_mul_f32 v34, v20, v16
    v_mul_f32 v30, v20, v21
    v_fmac_f32 v34, v22, v17
    v_fmac_f32 v30, v22, v23
    v_fmac_f32 v34, v24, v18
    v_fmac_f32 v30, v24, v25
    v_fmac_f32 v34, v26, v19
    v_fmac_f32 v30, v26, v27
    v_mov_b32 v35, s28
    v_mov_b32 v29, s28
    v_mov_b32 v31, s28
    buffer_store_dwordx2 v[34:35], v54, s[36:39], s88 offen sc1
    s_cmp_lg_u32 s86, 0
    s_cbranch_scc1 F_nostat
    s_mov_b64 exec, 1
    buffer_store_dwordx4 v[28:31], v55, s[36:39], s89 offen sc1
    s_mov_b64 exec, -1
F_nostat:
    s_cmp_ge_u32 s79, 208
    s_cbranch_scc1 F_nogu
    s_call_b64 s[98:99], SUB_S1C
F_nogu:
    s_cmp_eq_u32 s33, 1
    s_cbranch_scc1 F_s4pre
    s_mov_b32 s72, 3
    s_mov_b32 s73, 21504
    s_cmp_eq_u32 s33, 2
    s_cbranch_scc1 F_s2_go
    s_cmp_lt_u32 s95, 46
    s_cbranch_scc1 F_s2_done
    s_sub_u32 s60, s95, 46
    s_mul_i32 s70, s60, 57
    s_lshr_b32 s70, s70, 9
    s_mul_i32 s61, s70, 9
    s_sub_u32 s71, s60, s61
    s_add_u32 s70, s70, 16
    s_mov_b32 s72, 1
    s_mov_b32 s73, 95232
F_s2_go:
    v_add_u32 v12, s73, v60
    v_lshrrev_b32 v14, 3, v1
    s_mov_b32 s60, 53248
    v_mul_lo_u32 v14, v14, s60
    v_and_b32 v10, 7, v1
    v_lshl_add_u32 v14, v10, 5, v14
    s_lshl_b32 s60, s70, 2
    s_add_u32 s60, s60, s34
    s_lshl_b32 s60, s60, 8
    s_add_u32 s73, s60, 20480
    s_add_u32 s74, s60, 38912
    s_mov_b32 s67, 200000
L_gu_poll_8:
    buffer_load_dwordx4 v[100:103], v14, s[36:39], s73 offen sc1
    buffer_load_dwordx4 v[104:107], v14, s[36:39], s73 offen offset:16 sc1
    buffer_load_dwordx4 v[108:111], v14, s[36:39], s74 offen sc1
    buffer_load_dwordx4 v[112:115], v14, s[36:39], s74 offen offset:16 sc1
    s_waitcnt vmcnt(0)
L_gu_chk_10:
    v_xor_b32 v101, s28, v101
    v_xor_b32 v103, s28, v103
    v_xor_b32 v105, s28, v105
    v_xor_b32 v107, s28, v107
    v_xor_b32 v109, s28, v109
    v_xor_b32 v111, s28, v111
    v_xor_b32 v113, s28, v113
    v_xor_b32 v115, s28, v115
    v_or3_b32 v32, v101, v103, v105
    v_or3_b32 v32, v32, v107, v109
    v_or3_b32 v32, v32, v111, v113
    v_or_b32 v32, v32, v115
    v_cmp_ne_u32 vcc, 0, v32
    s_nop 4
    s_cbranch_vccz L_gu_ok_9
    s_sleep 2
    s_sub_u32 s67, s67, 1
    s_cmp_lg_u32 s67, 0
    s_cbranch_scc1 L_gu_poll_8
L_gu_ok_9:
    v_lshlrev_b32 v32, 16, v100
    v_lshlrev_b32 v33, 16, v108
    v_mul_f32 v34, 0xbfb8aa3b, v32
    v_exp_f32 v34, v34
    s_nop 0
    v_add_f32 v34, 1.0, v34
    v_rcp_f32 v35, v34
    s_nop 0
    v_mul_f32 v36, v32, v35
    v_fma_f32 v38, -v36, v34, v32
    v_fma_f32 v36, v38, v35, v36
    v_cvt_pk_bf16_f32 v36, v36, v36
    v_and_b32 v36, 0xffff0000, v36
    v_mul_f32 v36, v36, v33
    v_and_b32 v32, 0xffff0000, v100
    v_and_b32 v33, 0xffff0000, v108
    v_mul_f32 v34, 0xbfb8aa3b, v32
    v_exp_f32 v34, v34
    s_nop 0
    v_add_f32 v34, 1.0, v34
    v_rcp_f32 v35, v34
    s_nop 0
    v_mul_f32 v37, v32, v35
    v_fma_f32 v38, -v37, v34, v32
    v_fma_f32 v37, v38, v35, v37
    v_cvt_pk_bf16_f32 v37, v37, v37
    v_and_b32 v37, 0xffff0000, v37
    v_mul_f32 v37, v37, v33
    v_cvt_pk_bf16_f32 v116, v36, v37
    v_lshlrev_b32 v32, 16, v102
    v_lshlrev_b32 v33, 16, v110
    v_mul_f32 v34, 0xbfb8aa3b, v32
    v_exp_f32 v34, v34
    s_nop 0
    v_add_f32 v34, 1.0, v34
    v_rcp_f32 v35, v34
    s_nop 0
    v_mul_f32 v36, v32, v35
    v_fma_f32 v38, -v36, v34, v32
    v_fma_f32 v36, v38, v35, v36
    v_cvt_pk_bf16_f32 v36, v36, v36
    v_and_b32 v36, 0xffff0000, v36
    v_mul_f32 v36, v36, v33
    v_and_b32 v32, 0xffff0000, v102
    v_and_b32 v33, 0xffff0000, v110
    v_mul_f32 v34, 0xbfb8aa3b, v32
    v_exp_f32 v34, v34
    s_nop 0
    v_add_f32 v34, 1.0, v34
    v_rcp_f32 v35, v34
    s_nop 0
    v_mul_f32 v37, v32, v35
    v_fma_f32 v38, -v37, v34, v32
    v_fma_f32 v37, v38, v35, v37
    v_cvt_pk_bf16_f32 v37, v37, v37
    v_and_b32 v37, 0xffff0000, v37
    v_mul_f32 v37, v37, v33
    v_cvt_pk_bf16_f32 v117, v36, v37
    v_lshlrev_b32 v32, 16, v104
    v_lshlrev_b32 v33, 16, v112
    v_mul_f32 v34, 0xbfb8aa3b, v32
    v_exp_f32 v34, v34
    s_nop 0
    v_add_f32 v34, 1.0, v34
    v_rcp_f32 v35, v34
    s_nop 0
    v_mul_f32 v36, v32, v35
    v_fma_f32 v38, -v36, v34, v32
    v_fma_f32 v36, v38, v35, v36
    v_cvt_pk_bf16_f32 v36, v36, v36
    v_and_b32 v36, 0xffff0000, v36
    v_mul_f32 v36, v36, v33
    v_and_b32 v32, 0xffff0000, v104
    v_and_b32 v33, 0xffff0000, v112
    v_mul_f32 v34, 0xbfb8aa3b, v32
    v_exp_f32 v34, v34
    s_nop 0
    v_add_f32 v34, 1.0, v34
    v_rcp_f32 v35, v34
    s_nop 0
    v_mul_f32 v37, v32, v35
    v_fma_f32 v38, -v37, v34, v32
    v_fma_f32 v37, v38, v35, v37
    v_cvt_pk_bf16_f32 v37, v37, v37
    v_and_b32 v37, 0xffff0000, v37
    v_mul_f32 v37, v37, v33
    v_cvt_pk_bf16_f32 v118, v36, v37
    v_lshlrev_b32 v32, 16, v106
    v_lshlrev_b32 v33, 16, v114
    v_mul_f32 v34, 0xbfb8aa3b, v32
    v_exp_f32 v34, v34
    s_nop 0
    v_add_f32 v34, 1.0, v34
    v_rcp_f32 v35, v34
    s_nop 0
    v_mul_f32 v36, v32, v35
    v_fma_f32 v38, -v36, v34, v32
    v_fma_f32 v36, v38, v35, v36
    v_cvt_pk_bf16_f32 v36, v36, v36
    v_and_b32 v36, 0xffff0000, v36
    v_mul_f32 v36, v36, v33
    v_and_b32 v32, 0xffff0000, v106
    v_and_b32 v33, 0xffff0000, v114
    v_mul_f32 v34, 0xbfb8aa3b, v32
    v_exp_f32 v34, v34
    s_nop 0
    v_add_f32 v34, 1.0, v34
    v_rcp_f32 v35, v34
    s_nop 0
    v_mul_f32 v37, v32, v35
    v_fma_f32 v38, -v37, v34, v32
    v_fma_f32 v37, v38, v35, v37
    v_cvt_pk_bf16_f32 v37, v37, v37
    v_and_b32 v37, 0xffff0000, v37
    v_mul_f32 v37, v37, v33
    v_cvt_pk_bf16_f32 v119, v36, v37
    v_lshrrev_b32 v14, 3, v1
    v_mul_u32_u24 v14, 544, v14
    v_and_b32 v10, 7, v1
    v_lshl_add_u32 v14, v10, 4, v14
    s_lshl_b32 s60, s34, 7
    v_add_u32 v14, s60, v14
    ds_write_b128 v14, v[116:119] offset:16896
    s_mul_i32 s76, s70, 9
    s_add_u32 s76, s76, s71
    s_add_u32 s76, s76, 144
    s_lshl_b32 s76, s76, 12
    s_add_u32 s76, s76, 1179648
    s_mov_b32 s68, 0
    s_waitcnt vmcnt(0)
    s_add_u32 s75, s75, 4
    s_waitcnt lgkmcnt(0)
    v_mov_b32 v34, 10496
    v_mov_b32 v35, 1
    s_mov_b64 exec, 1
    ds_add_u32 v34, v35
    s_mov_b64 exec, -1
    s_mov_b32 s66, 200000
L_hs_poll_11:
    ds_read_b32 v35, v34
    s_waitcnt lgkmcnt(0)
    v_readfirstlane_b32 s67, v35
    s_nop 3
    s_cmp_ge_u32 s67, s75
    s_cbranch_scc1 L_hs_ok_12
    s_sub_u32 s66, s66, 1
    s_cmp_lg_u32 s66, 0
    s_cbranch_scc1 L_hs_poll_11
L_hs_ok_12:
F_s2_loop:
    v_mov_b32 v56, v12
    v_mul_u32_u24 v57, 544, v61
    v_lshl_add_u32 v57, v2, 4, v57
    v_add_u32 v57, 16896, v57
    s_mov_b32 s69, 4
    s_call_b64 s[96:97], SUB_TU
    s_add_u32 s76, s76, 4096
    v_add_u32 v12, 32768, v12
    s_sub_u32 s72, s72, 1
    s_cmp_lg_u32 s72, 0
    s_cbranch_scc1 F_s2_loop
F_s2_done:
    s_cmp_lg_u32 s3, 5
    s_cbranch_scc1 L_nomaster_13
    s_mov_b32 s52, s24
    s_mov_b32 s53, s25
    s_mov_b32 s54, 256
    s_mov_b32 s55, 0x00020000
    v_mov_b32 v55, 0
    v_mov_b32 v36, 1
    s_mov_b64 exec, 1
    buffer_atomic_add v36, v55, s[52:55], 0 offen sc0 sc1
    s_waitcnt vmcnt(0)
    v_readfirstlane_b32 s60, v36
    s_nop 3
    s_sub_u32 s60, s60, s100
    s_cmp_lg_u32 s60, 255
    s_cbranch_scc1 L_nomaster2_14
    v_mov_b32 v36, s28
    buffer_store_dword v36, v55, s[36:39], 0 offen offset:0 sc1
L_nomaster2_14:
    s_mov_b64 exec, -1
L_nomaster_13:
    s_cmp_ge_u32 s92, 72
    s_cbranch_scc1 F_end
    s_mov_b32 s52, s4
    s_mov_b32 s53, s5
    s_mov_b32 s54, 9216
    s_mov_b32 s55, 0x00020000
    buffer_load_dword v50, v13, s[52:55], s82 offen
    s_mov_b32 s67, 200000
L_ffn_poll_15:
    s_add_u32 s60, s81, 589824
    buffer_load_dwordx4 v[100:103], v11, s[36:39], s60 offen sc1
    s_add_u32 s60, s60, 73728
    buffer_load_dwordx4 v[104:107], v11, s[36:39], s60 offen sc1
    s_add_u32 s60, s60, 73728
    buffer_load_dwordx4 v[108:111], v11, s[36:39], s60 offen sc1
    s_add_u32 s60, s60, 73728
    buffer_load_dwordx4 v[112:115], v11, s[36:39], s60 offen sc1
    s_add_u32 s60, s60, 73728
    buffer_load_dwordx4 v[116:119], v11, s[36:39], s60 offen sc1
    s_add_u32 s60, s60, 73728
    buffer_load_dwordx4 v[120:123], v11, s[36:39], s60 offen sc1
    s_add_u32 s60, s60, 73728
    buffer_load_dwordx4 v[124:127], v11, s[36:39], s60 offen sc1
    s_add_u32 s60, s60, 73728
    buffer_load_dwordx4 v[128:131], v11, s[36:39], s60 offen sc1
    s_add_u32 s60, s60, 73728
    buffer_load_dwordx4 v[132:135], v11, s[36:39], s60 offen sc1
    s_waitcnt vmcnt(0)
L_ffn_chk_17:
    v_xor_b32 v101, s28, v101
    v_xor_b32 v103, s28, v103
    v_xor_b32 v105, s28, v105
    v_xor_b32 v107, s28, v107
    v_xor_b32 v109, s28, v109
    v_xor_b32 v111, s28, v111
    v_xor_b32 v113, s28, v113
    v_xor_b32 v115, s28, v115
    v_xor_b32 v117, s28, v117
    v_xor_b32 v119, s28, v119
    v_xor_b32 v121, s28, v121
    v_xor_b32 v123, s28, v123
    v_xor_b32 v125, s28, v125
    v_xor_b32 v127, s28, v127
    v_xor_b32 v129, s28, v129
    v_xor_b32 v131, s28, v131
    v_xor_b32 v133, s28, v133
    v_xor_b32 v135, s28, v135
    v_or3_b32 v32, v101, v103, v105
    v_or3_b32 v32, v32, v107, v109
    v_or3_b32 v32, v32, v111, v113
    v_or3_b32 v32, v32, v115, v117
    v_or3_b32 v32, v32, v119, v121
    v_or3_b32 v32, v32, v123, v125
    v_or3_b32 v32, v32, v127, v129
    v_or3_b32 v32, v32, v131, v133
    v_or_b32 v32, v32, v135
    v_cmp_ne_u32 vcc, 0, v32
    s_nop 4
    s_cbranch_vccz L_ffn_ok_16
    s_sleep 2
    s_sub_u32 s67, s67, 1
    s_cmp_lg_u32 s67, 0
    s_cbranch_scc1 L_ffn_poll_15
L_ffn_ok_16:
    v_mov_b32 v48, v100
    v_mov_b32 v49, v102
    v_add_f32 v48, v48, v104
    v_add_f32 v49, v49, v106
    v_add_f32 v48, v48, v108
    v_add_f32 v49, v49, v110
    v_add_f32 v48, v48, v112
    v_add_f32 v49, v49, v114
    v_add_f32 v48, v48, v116
    v_add_f32 v49, v49, v118
    v_add_f32 v48, v48, v120
    v_add_f32 v49, v49, v122
    v_add_f32 v48, v48, v124
    v_add_f32 v49, v49, v126
    v_add_f32 v48, v48, v128
    v_add_f32 v49, v49, v130
    v_add_f32 v48, v48, v132
    v_add_f32 v49, v49, v134
    v_mov_b32 v32, v48
    v_mov_b32 v33, v49
    s_nop 1
    v_permlane32_swap_b32 v48, v32
    v_permlane32_swap_b32 v49, v33
    s_nop 1
    v_add_f32 v48, v48, v32
    v_add_f32 v49, v49, v33
    s_mov_b32 s67, 200000
L_fin_poll_18:
    s_mov_b32 s60, s81
    buffer_load_dwordx4 v[100:103], v11, s[36:39], s60 offen sc1
    s_add_u32 s60, s60, 73728
    buffer_load_dwordx4 v[104:107], v11, s[36:39], s60 offen sc1
    s_add_u32 s60, s60, 73728
    buffer_load_dwordx4 v[108:111], v11, s[36:39], s60 offen sc1
    s_add_u32 s60, s60, 73728
    buffer_load_dwordx4 v[112:115], v11, s[36:39], s60 offen sc1
    s_add_u32 s60, s60, 73728
    buffer_load_dwordx4 v[116:119], v11, s[36:39], s60 offen sc1
    s_add_u32 s60, s60, 73728
    buffer_load_dwordx4 v[120:123], v11, s[36:39], s60 offen sc1
    s_add_u32 s60, s60, 73728
    buffer_load_dwordx4 v[124:127], v11, s[36:39], s60 offen sc1
    s_add_u32 s60, s60, 73728
    buffer_load_dwordx4 v[128:131], v11, s[36:39], s60 offen sc1
    s_waitcnt vmcnt(0)
L_fin_chk_20:
    v_xor_b32 v101, s28, v101
    v_xor_b32 v103, s28, v103
    v_xor_b32 v105, s28, v105
    v_xor_b32 v107, s28, v107
    v_xor_b32 v109, s28, v109
    v_xor_b32 v111, s28, v111
    v_xor_b32 v113, s28, v113
    v_xor_b32 v115, s28, v115
    v_xor_b32 v117, s28, v117
    v_xor_b32 v119, s28, v119
    v_xor_b32 v121, s28, v121
    v_xor_b32 v123, s28, v123
    v_xor_b32 v125, s28, v125
    v_xor_b32 v127, s28, v127
    v_xor_b32 v129, s28, v129
    v_xor_b32 v131, s28, v131
    v_or3_b32 v32, v101, v103, v105
    v_or3_b32 v32, v32, v107, v109
    v_or3_b32 v32, v32, v111, v113
    v_or3_b32 v32, v32, v115, v117
    v_or3_b32 v32, v32, v119, v121
    v_or3_b32 v32, v32, v123, v125
    v_or3_b32 v32, v32, v127, v129
    v_or_b32 v32, v32, v131
    v_cmp_ne_u32 vcc, 0, v32
    s_nop 4
    s_cbranch_vccz L_fin_ok_19
    s_sleep 1
    s_sub_u32 s67, s67, 1
    s_cmp_lg_u32 s67, 0
    s_cbranch_scc1 L_fin_poll_18
L_fin_ok_19:
    v_add_f32 v34, v100, v104
    v_add_f32 v35, v102, v106
    v_add_f32 v34, v34, v108
    v_add_f32 v35, v35, v110
    v_add_f32 v34, v34, v112
    v_add_f32 v35, v35, v114
    v_add_f32 v34, v34, v116
    v_add_f32 v35, v35, v118
    v_add_f32 v34, v34, v120
    v_add_f32 v35, v35, v122
    v_add_f32 v34, v34, v124
    v_add_f32 v35, v35, v126
    v_add_f32 v34, v34, v128
    v_add_f32 v35, v35, v130
    v_mov_b32 v32, v34
    v_mov_b32 v33, v35
    s_nop 1
    v_permlane32_swap_b32 v34, v32
    v_permlane32_swap_b32 v35, v33
    s_nop 1
    v_add_f32 v34, v34, v32
    v_add_f32 v35, v35, v33
    v_cvt_pk_bf16_f32 v36, v34, v35
    v_cvt_pk_bf16_f32 v37, v48, v49
    v_lshlrev_b32 v34, 16, v36
    v_and_b32 v35, 0xffff0000, v36
    v_lshlrev_b32 v38, 16, v50
    v_and_b32 v39, 0xffff0000, v50
    v_add_f32 v34, v34, v38
    v_add_f32 v35, v35, v39
    v_cvt_pk_bf16_f32 v36, v34, v35
    v_lshlrev_b32 v34, 16, v36
    v_and_b32 v35, 0xffff0000, v36
    v_lshlrev_b32 v38, 16, v37
    v_and_b32 v39, 0xffff0000, v37
    v_add_f32 v34, v34, v38
    v_add_f32 v35, v35, v39
    v_cvt_pk_bf16_f32 v36, v34, v35
    s_mov_b64 exec, 0xffffffff
    buffer_store_dword v36, v13, s[56:59], s82 offen
    s_branch F_end
F_s4pre:
    v_add_u32 v56, 95232, v60
    v_mul_u32_u24 v57, 544, v61
    v_lshl_add_u32 v57, v2, 4, v57
    v_add_u32 v57, 16896, v57
    s_lshl_b32 s76, s95, 12
    s_add_u32 s76, s76, 1179648
    s_mov_b32 s68, 0
    s_mov_b32 s69, 4
F_s4gather:
    v_lshlrev_b32 v50, 5, v1
    v_lshrrev_b32 v51, 5, v1
    v_lshlrev_b32 v51, 4, v51
    v_add_u32 v51, 2048, v51
    s_mov_b32 s67, 200000
L_s4g_poll_21:
    buffer_load_dwordx4 v[100:103], v50, s[36:39], s83 offen sc1
    buffer_load_dwordx4 v[104:107], v50, s[36:39], s83 offen offset:16 sc1
    buffer_load_dwordx4 v[108:111], v51, s[36:39], s83 offen sc1
    buffer_load_dwordx4 v[112:115], v50, s[36:39], s84 offen sc1
    buffer_load_dwordx4 v[116:119], v50, s[36:39], s84 offen offset:16 sc1
    buffer_load_dwordx4 v[120:123], v51, s[36:39], s84 offen sc1
    s_waitcnt vmcnt(0)
L_s4g_chk_23:
    v_xor_b32 v101, s28, v101
    v_xor_b32 v103, s28, v103
    v_xor_b32 v105, s28, v105
    v_xor_b32 v107, s28, v107
    v_xor_b32 v109, s28, v109
    v_xor_b32 v111, s28, v111
    v_xor_b32 v113, s28, v113
    v_xor_b32 v115, s28, v115
    v_xor_b32 v117, s28, v117
    v_xor_b32 v119, s28, v119
    v_xor_b32 v121, s28, v121
    v_xor_b32 v123, s28, v123
    v_or3_b32 v44, v101, v103, v105
    v_or3_b32 v44, v44, v107, v109
    v_or3_b32 v44, v44, v111, v113
    v_or3_b32 v44, v44, v115, v117
    v_or3_b32 v44, v44, v119, v121
    v_or_b32 v44, v44, v123
    v_cmp_ne_u32 vcc, 0, v44
    s_nop 4
    s_cbranch_vccz L_s4g_ok_22
    s_sleep 1
    s_sub_u32 s67, s67, 1
    s_cmp_lg_u32 s67, 0
    s_cbranch_scc1 L_s4g_poll_21
L_s4g_ok_22:
    v_max_f32 v44, v108, v120
    v_sub_f32 v45, v108, v44
    v_sub_f32 v46, v120, v44
    s_mov_b32 s63, 0x3fb8aa3b
    v_mul_f32 v45, s63, v45
    v_mul_f32 v46, s63, v46
    v_exp_f32 v45, v45
    v_exp_f32 v46, v46
    s_nop 0
    v_mul_f32 v47, v45, v110
    v_fmac_f32 v47, v46, v122
    v_rcp_f32 v44, v47
    s_nop 0
    v_mul_f32 v48, v45, v100
    v_fmac_f32 v48, v46, v112
    v_mul_f32 v40, v48, v44
    v_fma_f32 v49, -v40, v47, v48
    v_fma_f32 v40, v49, v44, v40
    v_mul_f32 v48, v45, v102
    v_fmac_f32 v48, v46, v114
    v_mul_f32 v41, v48, v44
    v_fma_f32 v49, -v41, v47, v48
    v_fma_f32 v41, v49, v44, v41
    v_mul_f32 v48, v45, v104
    v_fmac_f32 v48, v46, v116
    v_mul_f32 v42, v48, v44
    v_fma_f32 v49, -v42, v47, v48
    v_fma_f32 v42, v49, v44, v42
    v_mul_f32 v48, v45, v106
    v_fmac_f32 v48, v46, v118
    v_mul_f32 v43, v48, v44
    v_fma_f32 v49, -v43, v47, v48
    v_fma_f32 v43, v49, v44, v43
    v_cvt_pk_bf16_f32 v40, v40, v41
    v_cvt_pk_bf16_f32 v41, v42, v43
    ds_write_b64 v15, v[40:41] offset:16896
    s_waitcnt lgkmcnt(0)
    s_barrier
    s_cmp_lt_u32 s3, 4
    s_cbranch_scc1 F_end
    s_waitcnt vmcnt(0)
    s_call_b64 s[96:97], SUB_TU
    s_cmp_lg_u32 s3, 5
    s_cbranch_scc1 L_nomaster_24
    s_mov_b32 s52, s24
    s_mov_b32 s53, s25
    s_mov_b32 s54, 256
    s_mov_b32 s55, 0x00020000
    v_mov_b32 v55, 0
    v_mov_b32 v36, 1
    s_mov_b64 exec, 1
    buffer_atomic_add v36, v55, s[52:55], 0 offen sc0 sc1
    s_waitcnt vmcnt(0)
    v_readfirstlane_b32 s60, v36
    s_nop 3
    s_sub_u32 s60, s60, s100
    s_cmp_lg_u32 s60, 255
    s_cbranch_scc1 L_nomaster2_25
    v_mov_b32 v36, s28
    buffer_store_dword v36, v55, s[36:39], 0 offen offset:0 sc1
L_nomaster2_25:
    s_mov_b64 exec, -1
L_nomaster_24:
F_end:
F_end2:
    s_endpgm
SUB_TU:
    v_mov_b32 v16, 0
    v_mov_b32 v17, 0
    v_mov_b32 v18, 0
    v_mov_b32 v19, 0
    ds_read_b128 v[64:67], v57 offset:0
    ds_read_b64_tr_b16 v[72:73], v56 offset:0
    ds_read_b64_tr_b16 v[74:75], v56 offset:512
    ds_read_b128 v[68:71], v57 offset:64
    ds_read_b64_tr_b16 v[76:77], v56 offset:4096
    ds_read_b64_tr_b16 v[78:79], v56 offset:4608
    v_add_u32 v57, 128, v57
    v_add_u32 v56, 8192, v56
TU_loop:
    ds_read_b128 v[80:83], v57 offset:0
    ds_read_b64_tr_b16 v[88:89], v56 offset:0
    ds_read_b64_tr_b16 v[90:91], v56 offset:512
    ds_read_b128 v[84:87], v57 offset:64
    ds_read_b64_tr_b16 v[92:93], v56 offset:4096
    ds_read_b64_tr_b16 v[94:95], v56 offset:4608
    v_add_u32 v57, 128, v57
    v_add_u32 v56, 8192, v56
    s_waitcnt lgkmcnt(6)
    v_mfma_f32_16x16x32_bf16 v[16:19], v[64:67], v[72:75], v[16:19]
    v_mfma_f32_16x16x32_bf16 v[16:19], v[68:71], v[76:79], v[16:19]
    s_sub_u32 s69, s69, 1
    s_cmp_eq_u32 s69, 0
    s_cbranch_scc1 TU_done
    ds_read_b128 v[64:67], v57 offset:0
    ds_read_b64_tr_b16 v[72:73], v56 offset:0
    ds_read_b64_tr_b16 v[74:75], v56 offset:512
    ds_read_b128 v[68:71], v57 offset:64
    ds_read_b64_tr_b16 v[76:77], v56 offset:4096
    ds_read_b64_tr_b16 v[78:79], v56 offset:4608
    v_add_u32 v57, 128, v57
    v_add_u32 v56, 8192, v56
    s_waitcnt lgkmcnt(6)
    v_mfma_f32_16x16x32_bf16 v[16:19], v[80:83], v[88:91], v[16:19]
    v_mfma_f32_16x16x32_bf16 v[16:19], v[84:87], v[92:95], v[16:19]
    s_sub_u32 s69, s69, 1
    s_cmp_lg_u32 s69, 0
    s_cbranch_scc1 TU_loop
TU_done:
    s_mov_b32 s60, 0
    s_mov_b32 s61, -1
    s_mov_b32 s62, 0xaaaaaaaa
    s_mov_b32 s63, 0xaaaaaaaa
    s_nop 4
    v_cndmask_b32 v32, v16, v18, s[60:61]
    v_cndmask_b32 v33, v17, v19, s[60:61]
    s_nop 1
    v_mov_b32_dpp v34, v32 quad_perm:[1,0,3,2] row_mask:0xf bank_mask:0xf
    v_mov_b32_dpp v35, v33 quad_perm:[1,0,3,2] row_mask:0xf bank_mask:0xf
    v_cndmask_b32 v36, v32, v35, s[62:63]
    v_cndmask_b32 v38, v34, v33, s[62:63]
    s_cmp_eq_u32 s68, 1
    s_cbranch_scc1 TU_bf
    v_mov_b32 v37, s28
    v_mov_b32 v39, s28
    buffer_store_dwordx4 v[36:39], v58, s[36:39], s76 offen sc1
    s_waitcnt lgkmcnt(0)
    s_setpc_b64 s[96:97]
TU_bf:
    v_cvt_pk_bf16_f32 v36, v36, v38
    v_mov_b32 v37, s28
    buffer_store_dwordx2 v[36:37], v59, s[36:39], s76 offen sc1
    s_waitcnt lgkmcnt(0)
    s_setpc_b64 s[96:97]
SUB_WD:
    s_mov_b32 m0, s62
    s_add_u32 s62, s62, 1024
    buffer_load_dwordx4 v10, s[48:51], s60 offen nt lds
    s_mov_b32 m0, s62
    s_add_u32 s60, s60, s61
    s_add_u32 s62, s62, 1024
    buffer_load_dwordx4 v14, s[48:51], s60 offen nt lds
    s_add_u32 s60, s60, s61
    s_sub_u32 s63, s63, 1
    s_cmp_lg_u32 s63, 0
    s_cbranch_scc1 SUB_WD
    s_setpc_b64 s[96:97]
SUB_S1DMA:
    s_mov_b32 s70, 8192
    s_lshl_b32 s71, s79, 7
    s_mov_b32 s62, s10
    s_mov_b32 s63, s11
    s_cmp_lt_u32 s79, 64
    s_cbranch_scc1 S1_sel
    s_mov_b32 s70, 9216
    s_sub_u32 s71, s71, 8192
    s_mov_b32 s62, s16
    s_mov_b32 s63, s17
    s_cmp_lt_u32 s79, 136
    s_cbranch_scc1 S1_sel
    s_sub_u32 s71, s71, 9216
    s_mov_b32 s62, s18
    s_mov_b32 s63, s19
S1_sel:
    s_mul_i32 s67, s70, 576
    s_sub_u32 s67, s67, s71
    s_add_u32 s48, s62, s71
    s_addc_u32 s49, s63, 0
    s_mov_b32 s50, s67
    s_mov_b32 s51, 0x00020000
    v_lshrrev_b32 v10, 3, v1
    v_mul_lo_u32 v10, v10, s70
    v_bfe_u32 v32, v1, 4, 1
    v_lshlrev_b32 v32, 1, v32
    v_and_b32 v33, 7, v1
    v_xor_b32 v32, v32, v33
    v_xor_b32 v33, 4, v32
    v_lshl_add_u32 v14, v33, 4, v10
    v_lshl_add_u32 v10, v32, 4, v10
    s_mul_i32 s60, s34, 144
    s_mul_i32 s60, s60, s70
    s_lshl_b32 s61, s70, 3
    s_mul_i32 s62, s34, 18432
    s_add_u32 s62, s62, 21504
    s_mov_b32 s63, 9
    s_call_b64 s[96:97], SUB_WD
    s_setpc_b64 s[98:99]
SUB_S1C:
    v_mul_u32_u24 v57, 1312, v61
    v_lshl_add_u32 v57, v2, 4, v57
    v_add_u32 v56, 21504, v60
    s_mov_b32 s69, 9
    s_lshl_b32 s76, s79, 8
    s_add_u32 s76, s76, 4096
    s_mov_b32 s68, 1
    s_waitcnt vmcnt(0)
    s_add_u32 s75, s75, 4
    s_waitcnt lgkmcnt(0)
    v_mov_b32 v34, 10496
    v_mov_b32 v35, 1
    s_mov_b64 exec, 1
    ds_add_u32 v34, v35
    s_mov_b64 exec, -1
    s_mov_b32 s66, 200000
L_hs_poll_26:
    ds_read_b32 v35, v34
    s_waitcnt lgkmcnt(0)
    v_readfirstlane_b32 s67, v35
    s_nop 3
    s_cmp_ge_u32 s67, s75
    s_cbranch_scc1 L_hs_ok_27
    s_sub_u32 s66, s66, 1
    s_cmp_lg_u32 s66, 0
    s_cbranch_scc1 L_hs_poll_26
L_hs_ok_27:
    s_call_b64 s[96:97], SUB_TU
    s_add_u32 s75, s75, 4
    s_waitcnt lgkmcnt(0)
    v_mov_b32 v34, 10496
    v_mov_b32 v35, 1
    s_mov_b64 exec, 1
    ds_add_u32 v34, v35
    s_mov_b64 exec, -1
    s_mov_b32 s66, 200000
L_hs_poll_28:
    ds_read_b32 v35, v34
    s_waitcnt lgkmcnt(0)
    v_readfirstlane_b32 s67, v35
    s_nop 3
    s_cmp_ge_u32 s67, s75
    s_cbranch_scc1 L_hs_ok_29
    s_sub_u32 s66, s66, 1
    s_cmp_lg_u32 s66, 0
    s_cbranch_scc1 L_hs_poll_28
L_hs_ok_29:
    s_setpc_b64 s[98:99]
.section .rodata,"a"
.p2align 6
.amdhsa_kernel parallel_sum__gqa_block_cached__swiglu_ffn__decode_kernel
  .amdhsa_next_free_vgpr 256
  .amdhsa_next_free_sgpr 102
  .amdhsa_accum_offset 256
  .amdhsa_group_segment_fixed_size 0
  .amdhsa_kernarg_size 96
  .amdhsa_user_sgpr_count 2
  .amdhsa_user_sgpr_kernarg_segment_ptr 1
  .amdhsa_system_sgpr_workgroup_id_x 1
.end_amdhsa_kernel
```
